```python
import torch

def _softmax(x, axis=-1):
    return torch.softmax(x, dim=axis)
def _gelu(x):
    return torch.nn.functional.gelu(x, approximate="tanh")
def _silu(x):
    return torch.nn.functional.silu(x)
def _sigmoid(x):
    return torch.sigmoid(x)
def _layernorm(x, axis=-1, eps=1e-5):
    m = x.mean(dim=axis, keepdim=True)
    v = x.var(dim=axis, keepdim=True, unbiased=False)
    return (x - m) / torch.sqrt(v + eps)
def _scatter_add(tgt, idx, src, axis=0):
    return tgt.clone().index_add_(axis, idx, src)
def _segment_sum(src, seg, n):
    out = torch.zeros((n,) + src.shape[1:], dtype=src.dtype)
    return out.index_add_(0, seg, src)
def _pad(x, pw):
    flat = tuple(v for pair in reversed(pw) for v in pair)
    return torch.nn.functional.pad(x, flat)

kernel_name = 'gather_scatter__edge_featured_mpnn_mpnn__graph'

def setup_inputs():

    _w = (lambda a: (lambda t: t.to(torch.bfloat16) if t.is_floating_point() else t)(torch.as_tensor(a)))
    N, deg, D, De = 10000, 32, 128, max(0, 1)
    E = N * deg
    H = 2 * D
    return {
        "x": _w((lambda *s: torch.randn(*s, dtype=torch.bfloat16) * 0.05)(N, D)),
        "e_attr": _w((lambda *s: torch.randn(*s, dtype=torch.bfloat16) * 1.6)(E, De)),
        "src": _w((lambda lo, hi, *s: torch.randint(lo, hi, s))(0, N, E).to(torch.int64)),
        "dst": _w((lambda lo, hi, *s: torch.randint(lo, hi, s))(0, N, E).to(torch.int64)),
        "w1": _w((lambda *s: torch.randn(*s, dtype=torch.bfloat16) * 1.6)(2 * D + De, H) * (1.0 / (2 * D + De) ** 0.5)),
        "b1": _w((lambda *s: torch.randn(*s, dtype=torch.bfloat16) * 0.8)(H) * 0.01),
        "w2": _w((lambda *s: torch.randn(*s, dtype=torch.bfloat16) * 0.05)(H, D) * (1.0 / H ** 0.5)),
        "b2": _w((lambda *s: torch.randn(*s, dtype=torch.bfloat16) * 0.05)(D) * 0.01),
    }

def reference(x, e_attr, src, dst, w1, b1, w2, b2):
    N, D = x.shape
    h_src = x[src]
    h_dst = x[dst]
    m_in = torch.concatenate([h_src, h_dst, e_attr], axis=-1)
    h = _silu(m_in @ w1 + b1)
    msg = h @ w2 + b2
    return _segment_sum(msg, dst, N)
```

```asm
; @launch kernel=prep_kernel grid=(190,1,1) block=(1024,1,1) lds=120320
; @launch kernel=main_kernel grid=(256,1,1) block=(1024,1,1) lds=33792
.amdgcn_target "amdgcn-amd-amdhsa--gfx950"
.text
.globl prep_kernel
.p2align 8
.type prep_kernel,@function
prep_kernel:
    s_cmp_ge_u32 s2, 190
    s_cbranch_scc1 Lp_end
    s_load_dwordx16 s[4:19], s[0:1], 0
    s_load_dwordx4 s[20:23], s[0:1], 64
    s_load_dwordx2 s[24:25], s[0:1], 80
    s_waitcnt lgkmcnt(0)
    s_cmp_lt_u32 s2, 32
    s_cbranch_scc1 Lp_sort
    s_cmp_eq_u32 s2, 32
    s_cbranch_scc1 Lp_tr
    s_sub_u32 s3, s2, 33
    s_add_u32 s28, s4, 0
    s_addc_u32 s29, s5, 0
    s_mov_b32 s30, 2560000
    s_mov_b32 s31, 0x20000
    s_add_u32 s32, s12, 0
    s_addc_u32 s33, s13, 0
    s_mov_b32 s34, 131584
    s_mov_b32 s35, 0x20000
    s_add_u32 s36, s24, 0
    s_addc_u32 s37, s25, 0
    s_mov_b32 s38, 5120000
    s_mov_b32 s39, 0x20000
    s_add_u32 s40, s24, 5120000
    s_addc_u32 s41, s25, 0
    s_mov_b32 s42, 10240000
    s_mov_b32 s43, 0x20000
    s_add_u32 s44, s14, 0
    s_addc_u32 s45, s15, 0
    s_mov_b32 s46, 512
    s_mov_b32 s47, 0x20000
    v_and_b32 v1, 63, v0
    v_lshrrev_b32 v2, 6, v0
    v_and_b32 v3, 31, v1
    v_lshrrev_b32 v4, 5, v1
    v_lshl_add_u32 v5, v2, 5, v3
    v_lshlrev_b32 v6, 12, v4
    v_lshl_add_u32 v6, v5, 1, v6
    v_lshrrev_b32 v7, 3, v2
    v_mul_u32_u24 v7, 65024, v7
    v_add_u32 v6, v6, v7
    s_mov_b32 s50, 0
    buffer_load_ushort v64, v6, s[32:35], s50 offen offset:0
    buffer_load_ushort v65, v6, s[32:35], s50 offen offset:512
    buffer_load_ushort v66, v6, s[32:35], s50 offen offset:1024
    buffer_load_ushort v67, v6, s[32:35], s50 offen offset:1536
    buffer_load_ushort v68, v6, s[32:35], s50 offen offset:2048
    buffer_load_ushort v69, v6, s[32:35], s50 offen offset:2560
    buffer_load_ushort v70, v6, s[32:35], s50 offen offset:3072
    buffer_load_ushort v71, v6, s[32:35], s50 offen offset:3584
    s_mov_b32 s50, 8192
    buffer_load_ushort v72, v6, s[32:35], s50 offen offset:0
    buffer_load_ushort v73, v6, s[32:35], s50 offen offset:512
    buffer_load_ushort v74, v6, s[32:35], s50 offen offset:1024
    buffer_load_ushort v75, v6, s[32:35], s50 offen offset:1536
    buffer_load_ushort v76, v6, s[32:35], s50 offen offset:2048
    buffer_load_ushort v77, v6, s[32:35], s50 offen offset:2560
    buffer_load_ushort v78, v6, s[32:35], s50 offen offset:3072
    buffer_load_ushort v79, v6, s[32:35], s50 offen offset:3584
    s_mov_b32 s50, 16384
    buffer_load_ushort v80, v6, s[32:35], s50 offen offset:0
    buffer_load_ushort v81, v6, s[32:35], s50 offen offset:512
    buffer_load_ushort v82, v6, s[32:35], s50 offen offset:1024
    buffer_load_ushort v83, v6, s[32:35], s50 offen offset:1536
    buffer_load_ushort v84, v6, s[32:35], s50 offen offset:2048
    buffer_load_ushort v85, v6, s[32:35], s50 offen offset:2560
    buffer_load_ushort v86, v6, s[32:35], s50 offen offset:3072
    buffer_load_ushort v87, v6, s[32:35], s50 offen offset:3584
    s_mov_b32 s50, 24576
    buffer_load_ushort v88, v6, s[32:35], s50 offen offset:0
    buffer_load_ushort v89, v6, s[32:35], s50 offen offset:512
    buffer_load_ushort v90, v6, s[32:35], s50 offen offset:1024
    buffer_load_ushort v91, v6, s[32:35], s50 offen offset:1536
    buffer_load_ushort v92, v6, s[32:35], s50 offen offset:2048
    buffer_load_ushort v93, v6, s[32:35], s50 offen offset:2560
    buffer_load_ushort v94, v6, s[32:35], s50 offen offset:3072
    buffer_load_ushort v95, v6, s[32:35], s50 offen offset:3584
    s_mov_b32 s50, 32768
    buffer_load_ushort v96, v6, s[32:35], s50 offen offset:0
    buffer_load_ushort v97, v6, s[32:35], s50 offen offset:512
    buffer_load_ushort v98, v6, s[32:35], s50 offen offset:1024
    buffer_load_ushort v99, v6, s[32:35], s50 offen offset:1536
    buffer_load_ushort v100, v6, s[32:35], s50 offen offset:2048
    buffer_load_ushort v101, v6, s[32:35], s50 offen offset:2560
    buffer_load_ushort v102, v6, s[32:35], s50 offen offset:3072
    buffer_load_ushort v103, v6, s[32:35], s50 offen offset:3584
    s_mov_b32 s50, 40960
    buffer_load_ushort v104, v6, s[32:35], s50 offen offset:0
    buffer_load_ushort v105, v6, s[32:35], s50 offen offset:512
    buffer_load_ushort v106, v6, s[32:35], s50 offen offset:1024
    buffer_load_ushort v107, v6, s[32:35], s50 offen offset:1536
    buffer_load_ushort v108, v6, s[32:35], s50 offen offset:2048
    buffer_load_ushort v109, v6, s[32:35], s50 offen offset:2560
    buffer_load_ushort v110, v6, s[32:35], s50 offen offset:3072
    buffer_load_ushort v111, v6, s[32:35], s50 offen offset:3584
    s_mov_b32 s50, 49152
    buffer_load_ushort v112, v6, s[32:35], s50 offen offset:0
    buffer_load_ushort v113, v6, s[32:35], s50 offen offset:512
    buffer_load_ushort v114, v6, s[32:35], s50 offen offset:1024
    buffer_load_ushort v115, v6, s[32:35], s50 offen offset:1536
    buffer_load_ushort v116, v6, s[32:35], s50 offen offset:2048
    buffer_load_ushort v117, v6, s[32:35], s50 offen offset:2560
    buffer_load_ushort v118, v6, s[32:35], s50 offen offset:3072
    buffer_load_ushort v119, v6, s[32:35], s50 offen offset:3584
    s_mov_b32 s50, 57344
    buffer_load_ushort v120, v6, s[32:35], s50 offen offset:0
    buffer_load_ushort v121, v6, s[32:35], s50 offen offset:512
    buffer_load_ushort v122, v6, s[32:35], s50 offen offset:1024
    buffer_load_ushort v123, v6, s[32:35], s50 offen offset:1536
    buffer_load_ushort v124, v6, s[32:35], s50 offen offset:2048
    buffer_load_ushort v125, v6, s[32:35], s50 offen offset:2560
    buffer_load_ushort v126, v6, s[32:35], s50 offen offset:3072
    buffer_load_ushort v127, v6, s[32:35], s50 offen offset:3584
    v_lshlrev_b32 v7, 1, v5
    v_subrev_u32 v7, 512, v7
    buffer_load_ushort v8, v7, s[44:47], 0 offen
    v_readfirstlane_b32 s51, v2
    s_waitcnt vmcnt(0)
    v_lshl_or_b32 v64, v65, 16, v64
    v_lshl_or_b32 v65, v67, 16, v66
    v_lshl_or_b32 v66, v69, 16, v68
    v_lshl_or_b32 v67, v71, 16, v70
    v_lshl_or_b32 v68, v73, 16, v72
    v_lshl_or_b32 v69, v75, 16, v74
    v_lshl_or_b32 v70, v77, 16, v76
    v_lshl_or_b32 v71, v79, 16, v78
    v_lshl_or_b32 v72, v81, 16, v80
    v_lshl_or_b32 v73, v83, 16, v82
    v_lshl_or_b32 v74, v85, 16, v84
    v_lshl_or_b32 v75, v87, 16, v86
    v_lshl_or_b32 v76, v89, 16, v88
    v_lshl_or_b32 v77, v91, 16, v90
    v_lshl_or_b32 v78, v93, 16, v92
    v_lshl_or_b32 v79, v95, 16, v94
    v_lshl_or_b32 v80, v97, 16, v96
    v_lshl_or_b32 v81, v99, 16, v98
    v_lshl_or_b32 v82, v101, 16, v100
    v_lshl_or_b32 v83, v103, 16, v102
    v_lshl_or_b32 v84, v105, 16, v104
    v_lshl_or_b32 v85, v107, 16, v106
    v_lshl_or_b32 v86, v109, 16, v108
    v_lshl_or_b32 v87, v111, 16, v110
    v_lshl_or_b32 v88, v113, 16, v112
    v_lshl_or_b32 v89, v115, 16, v114
    v_lshl_or_b32 v90, v117, 16, v116
    v_lshl_or_b32 v91, v119, 16, v118
    v_lshl_or_b32 v92, v121, 16, v120
    v_lshl_or_b32 v93, v123, 16, v122
    v_lshl_or_b32 v94, v125, 16, v124
    v_lshl_or_b32 v95, v127, 16, v126
    s_mov_b32 s52, 0xbfb8aa3b
    s_lshl_b32 s53, s3, 6
    v_add_u32 v9, s53, v3
    v_lshlrev_b32 v9, 8, v9
    v_lshl_add_u32 v9, v4, 4, v9
    buffer_load_dwordx4 v[32:35], v9, s[28:31], 0 offen offset:0
    buffer_load_dwordx4 v[36:39], v9, s[28:31], 0 offen offset:32
    buffer_load_dwordx4 v[40:43], v9, s[28:31], 0 offen offset:64
    buffer_load_dwordx4 v[44:47], v9, s[28:31], 0 offen offset:96
    buffer_load_dwordx4 v[48:51], v9, s[28:31], 0 offen offset:128
    buffer_load_dwordx4 v[52:55], v9, s[28:31], 0 offen offset:160
    buffer_load_dwordx4 v[56:59], v9, s[28:31], 0 offen offset:192
    buffer_load_dwordx4 v[60:63], v9, s[28:31], 0 offen offset:224
    v_mov_b32 v16, 0
    v_mov_b32 v17, 0
    v_mov_b32 v18, 0
    v_mov_b32 v19, 0
    v_mov_b32 v20, 0
    v_mov_b32 v21, 0
    v_mov_b32 v22, 0
    v_mov_b32 v23, 0
    v_mov_b32 v24, 0
    v_mov_b32 v25, 0
    v_mov_b32 v26, 0
    v_mov_b32 v27, 0
    v_mov_b32 v28, 0
    v_mov_b32 v29, 0
    v_mov_b32 v30, 0
    v_mov_b32 v31, 0
    s_waitcnt vmcnt(0)
    v_mfma_f32_32x32x16_bf16 v[16:31], v[32:35], v[64:67], v[16:31]
    v_mfma_f32_32x32x16_bf16 v[16:31], v[36:39], v[68:71], v[16:31]
    v_mfma_f32_32x32x16_bf16 v[16:31], v[40:43], v[72:75], v[16:31]
    v_mfma_f32_32x32x16_bf16 v[16:31], v[44:47], v[76:79], v[16:31]
    v_mfma_f32_32x32x16_bf16 v[16:31], v[48:51], v[80:83], v[16:31]
    v_mfma_f32_32x32x16_bf16 v[16:31], v[52:55], v[84:87], v[16:31]
    v_mfma_f32_32x32x16_bf16 v[16:31], v[56:59], v[88:91], v[16:31]
    v_mfma_f32_32x32x16_bf16 v[16:31], v[60:63], v[92:95], v[16:31]
    s_nop 15
    s_nop 3
    v_lshl_add_u32 v10, v4, 2, s53
    s_cmp_ge_u32 s51, 8
    s_cbranch_scc1 Lp_base0
    v_lshlrev_b32 v11, 9, v10
    v_lshl_add_u32 v11, v5, 1, v11
    v_mul_f32 v16, s52, v16
    v_mul_f32 v17, s52, v17
    v_mul_f32 v18, s52, v18
    v_mul_f32 v19, s52, v19
    v_mul_f32 v20, s52, v20
    v_mul_f32 v21, s52, v21
    v_mul_f32 v22, s52, v22
    v_mul_f32 v23, s52, v23
    v_mul_f32 v24, s52, v24
    v_mul_f32 v25, s52, v25
    v_mul_f32 v26, s52, v26
    v_mul_f32 v27, s52, v27
    v_mul_f32 v28, s52, v28
    v_mul_f32 v29, s52, v29
    v_mul_f32 v30, s52, v30
    v_mul_f32 v31, s52, v31
    v_cvt_pk_bf16_f32 v16, v16, v16
    v_cvt_pk_bf16_f32 v17, v17, v17
    v_cvt_pk_bf16_f32 v18, v18, v18
    v_cvt_pk_bf16_f32 v19, v19, v19
    v_cvt_pk_bf16_f32 v20, v20, v20
    v_cvt_pk_bf16_f32 v21, v21, v21
    v_cvt_pk_bf16_f32 v22, v22, v22
    v_cvt_pk_bf16_f32 v23, v23, v23
    v_cvt_pk_bf16_f32 v24, v24, v24
    v_cvt_pk_bf16_f32 v25, v25, v25
    v_cvt_pk_bf16_f32 v26, v26, v26
    v_cvt_pk_bf16_f32 v27, v27, v27
    v_cvt_pk_bf16_f32 v28, v28, v28
    v_cvt_pk_bf16_f32 v29, v29, v29
    v_cvt_pk_bf16_f32 v30, v30, v30
    v_cvt_pk_bf16_f32 v31, v31, v31
    s_mov_b32 s54, 0
    buffer_store_short v16, v11, s[36:39], s54 offen
    s_mov_b32 s54, 512
    buffer_store_short v17, v11, s[36:39], s54 offen
    s_mov_b32 s54, 1024
    buffer_store_short v18, v11, s[36:39], s54 offen
    s_mov_b32 s54, 1536
    buffer_store_short v19, v11, s[36:39], s54 offen
    s_mov_b32 s54, 4096
    buffer_store_short v20, v11, s[36:39], s54 offen
    s_mov_b32 s54, 4608
    buffer_store_short v21, v11, s[36:39], s54 offen
    s_mov_b32 s54, 5120
    buffer_store_short v22, v11, s[36:39], s54 offen
    s_mov_b32 s54, 5632
    buffer_store_short v23, v11, s[36:39], s54 offen
    s_mov_b32 s54, 8192
    buffer_store_short v24, v11, s[36:39], s54 offen
    s_mov_b32 s54, 8704
    buffer_store_short v25, v11, s[36:39], s54 offen
    s_mov_b32 s54, 9216
    buffer_store_short v26, v11, s[36:39], s54 offen
    s_mov_b32 s54, 9728
    buffer_store_short v27, v11, s[36:39], s54 offen
    s_mov_b32 s54, 12288
    buffer_store_short v28, v11, s[36:39], s54 offen
    s_mov_b32 s54, 12800
    buffer_store_short v29, v11, s[36:39], s54 offen
    s_mov_b32 s54, 13312
    buffer_store_short v30, v11, s[36:39], s54 offen
    s_mov_b32 s54, 13824
    buffer_store_short v31, v11, s[36:39], s54 offen
    s_branch Lp_next0
Lp_base0:
    v_lshlrev_b32 v12, 16, v8
    v_lshlrev_b32 v11, 10, v10
    v_lshl_add_u32 v11, v5, 2, v11
    v_subrev_u32 v11, 1024, v11
    v_add_f32 v16, v16, v12
    v_mul_f32 v16, s52, v16
    v_add_f32 v17, v17, v12
    v_mul_f32 v17, s52, v17
    v_add_f32 v18, v18, v12
    v_mul_f32 v18, s52, v18
    v_add_f32 v19, v19, v12
    v_mul_f32 v19, s52, v19
    v_add_f32 v20, v20, v12
    v_mul_f32 v20, s52, v20
    v_add_f32 v21, v21, v12
    v_mul_f32 v21, s52, v21
    v_add_f32 v22, v22, v12
    v_mul_f32 v22, s52, v22
    v_add_f32 v23, v23, v12
    v_mul_f32 v23, s52, v23
    v_add_f32 v24, v24, v12
    v_mul_f32 v24, s52, v24
    v_add_f32 v25, v25, v12
    v_mul_f32 v25, s52, v25
    v_add_f32 v26, v26, v12
    v_mul_f32 v26, s52, v26
    v_add_f32 v27, v27, v12
    v_mul_f32 v27, s52, v27
    v_add_f32 v28, v28, v12
    v_mul_f32 v28, s52, v28
    v_add_f32 v29, v29, v12
    v_mul_f32 v29, s52, v29
    v_add_f32 v30, v30, v12
    v_mul_f32 v30, s52, v30
    v_add_f32 v31, v31, v12
    v_mul_f32 v31, s52, v31
    s_mov_b32 s54, 0
    buffer_store_dword v16, v11, s[40:43], s54 offen
    s_mov_b32 s54, 1024
    buffer_store_dword v17, v11, s[40:43], s54 offen
    s_mov_b32 s54, 2048
    buffer_store_dword v18, v11, s[40:43], s54 offen
    s_mov_b32 s54, 3072
    buffer_store_dword v19, v11, s[40:43], s54 offen
    s_mov_b32 s54, 8192
    buffer_store_dword v20, v11, s[40:43], s54 offen
    s_mov_b32 s54, 9216
    buffer_store_dword v21, v11, s[40:43], s54 offen
    s_mov_b32 s54, 10240
    buffer_store_dword v22, v11, s[40:43], s54 offen
    s_mov_b32 s54, 11264
    buffer_store_dword v23, v11, s[40:43], s54 offen
    s_mov_b32 s54, 16384
    buffer_store_dword v24, v11, s[40:43], s54 offen
    s_mov_b32 s54, 17408
    buffer_store_dword v25, v11, s[40:43], s54 offen
    s_mov_b32 s54, 18432
    buffer_store_dword v26, v11, s[40:43], s54 offen
    s_mov_b32 s54, 19456
    buffer_store_dword v27, v11, s[40:43], s54 offen
    s_mov_b32 s54, 24576
    buffer_store_dword v28, v11, s[40:43], s54 offen
    s_mov_b32 s54, 25600
    buffer_store_dword v29, v11, s[40:43], s54 offen
    s_mov_b32 s54, 26624
    buffer_store_dword v30, v11, s[40:43], s54 offen
    s_mov_b32 s54, 27648
    buffer_store_dword v31, v11, s[40:43], s54 offen
Lp_next0:
    s_lshl_b32 s53, s3, 6
    s_add_u32 s53, s53, 32
    v_add_u32 v9, s53, v3
    v_lshlrev_b32 v9, 8, v9
    v_lshl_add_u32 v9, v4, 4, v9
    buffer_load_dwordx4 v[32:35], v9, s[28:31], 0 offen offset:0
    buffer_load_dwordx4 v[36:39], v9, s[28:31], 0 offen offset:32
    buffer_load_dwordx4 v[40:43], v9, s[28:31], 0 offen offset:64
    buffer_load_dwordx4 v[44:47], v9, s[28:31], 0 offen offset:96
    buffer_load_dwordx4 v[48:51], v9, s[28:31], 0 offen offset:128
    buffer_load_dwordx4 v[52:55], v9, s[28:31], 0 offen offset:160
    buffer_load_dwordx4 v[56:59], v9, s[28:31], 0 offen offset:192
    buffer_load_dwordx4 v[60:63], v9, s[28:31], 0 offen offset:224
    v_mov_b32 v16, 0
    v_mov_b32 v17, 0
    v_mov_b32 v18, 0
    v_mov_b32 v19, 0
    v_mov_b32 v20, 0
    v_mov_b32 v21, 0
    v_mov_b32 v22, 0
    v_mov_b32 v23, 0
    v_mov_b32 v24, 0
    v_mov_b32 v25, 0
    v_mov_b32 v26, 0
    v_mov_b32 v27, 0
    v_mov_b32 v28, 0
    v_mov_b32 v29, 0
    v_mov_b32 v30, 0
    v_mov_b32 v31, 0
    s_waitcnt vmcnt(0)
    v_mfma_f32_32x32x16_bf16 v[16:31], v[32:35], v[64:67], v[16:31]
    v_mfma_f32_32x32x16_bf16 v[16:31], v[36:39], v[68:71], v[16:31]
    v_mfma_f32_32x32x16_bf16 v[16:31], v[40:43], v[72:75], v[16:31]
    v_mfma_f32_32x32x16_bf16 v[16:31], v[44:47], v[76:79], v[16:31]
    v_mfma_f32_32x32x16_bf16 v[16:31], v[48:51], v[80:83], v[16:31]
    v_mfma_f32_32x32x16_bf16 v[16:31], v[52:55], v[84:87], v[16:31]
    v_mfma_f32_32x32x16_bf16 v[16:31], v[56:59], v[88:91], v[16:31]
    v_mfma_f32_32x32x16_bf16 v[16:31], v[60:63], v[92:95], v[16:31]
    s_nop 15
    s_nop 3
    v_lshl_add_u32 v10, v4, 2, s53
    s_cmp_ge_u32 s51, 8
    s_cbranch_scc1 Lp_base1
    v_lshlrev_b32 v11, 9, v10
    v_lshl_add_u32 v11, v5, 1, v11
    v_mul_f32 v16, s52, v16
    v_mul_f32 v17, s52, v17
    v_mul_f32 v18, s52, v18
    v_mul_f32 v19, s52, v19
    v_mul_f32 v20, s52, v20
    v_mul_f32 v21, s52, v21
    v_mul_f32 v22, s52, v22
    v_mul_f32 v23, s52, v23
    v_mul_f32 v24, s52, v24
    v_mul_f32 v25, s52, v25
    v_mul_f32 v26, s52, v26
    v_mul_f32 v27, s52, v27
    v_mul_f32 v28, s52, v28
    v_mul_f32 v29, s52, v29
    v_mul_f32 v30, s52, v30
    v_mul_f32 v31, s52, v31
    v_cvt_pk_bf16_f32 v16, v16, v16
    v_cvt_pk_bf16_f32 v17, v17, v17
    v_cvt_pk_bf16_f32 v18, v18, v18
    v_cvt_pk_bf16_f32 v19, v19, v19
    v_cvt_pk_bf16_f32 v20, v20, v20
    v_cvt_pk_bf16_f32 v21, v21, v21
    v_cvt_pk_bf16_f32 v22, v22, v22
    v_cvt_pk_bf16_f32 v23, v23, v23
    v_cvt_pk_bf16_f32 v24, v24, v24
    v_cvt_pk_bf16_f32 v25, v25, v25
    v_cvt_pk_bf16_f32 v26, v26, v26
    v_cvt_pk_bf16_f32 v27, v27, v27
    v_cvt_pk_bf16_f32 v28, v28, v28
    v_cvt_pk_bf16_f32 v29, v29, v29
    v_cvt_pk_bf16_f32 v30, v30, v30
    v_cvt_pk_bf16_f32 v31, v31, v31
    s_mov_b32 s54, 0
    buffer_store_short v16, v11, s[36:39], s54 offen
    s_mov_b32 s54, 512
    buffer_store_short v17, v11, s[36:39], s54 offen
    s_mov_b32 s54, 1024
    buffer_store_short v18, v11, s[36:39], s54 offen
    s_mov_b32 s54, 1536
    buffer_store_short v19, v11, s[36:39], s54 offen
    s_mov_b32 s54, 4096
    buffer_store_short v20, v11, s[36:39], s54 offen
    s_mov_b32 s54, 4608
    buffer_store_short v21, v11, s[36:39], s54 offen
    s_mov_b32 s54, 5120
    buffer_store_short v22, v11, s[36:39], s54 offen
    s_mov_b32 s54, 5632
    buffer_store_short v23, v11, s[36:39], s54 offen
    s_mov_b32 s54, 8192
    buffer_store_short v24, v11, s[36:39], s54 offen
    s_mov_b32 s54, 8704
    buffer_store_short v25, v11, s[36:39], s54 offen
    s_mov_b32 s54, 9216
    buffer_store_short v26, v11, s[36:39], s54 offen
    s_mov_b32 s54, 9728
    buffer_store_short v27, v11, s[36:39], s54 offen
    s_mov_b32 s54, 12288
    buffer_store_short v28, v11, s[36:39], s54 offen
    s_mov_b32 s54, 12800
    buffer_store_short v29, v11, s[36:39], s54 offen
    s_mov_b32 s54, 13312
    buffer_store_short v30, v11, s[36:39], s54 offen
    s_mov_b32 s54, 13824
    buffer_store_short v31, v11, s[36:39], s54 offen
    s_branch Lp_next1
Lp_base1:
    v_lshlrev_b32 v12, 16, v8
    v_lshlrev_b32 v11, 10, v10
    v_lshl_add_u32 v11, v5, 2, v11
    v_subrev_u32 v11, 1024, v11
    v_add_f32 v16, v16, v12
    v_mul_f32 v16, s52, v16
    v_add_f32 v17, v17, v12
    v_mul_f32 v17, s52, v17
    v_add_f32 v18, v18, v12
    v_mul_f32 v18, s52, v18
    v_add_f32 v19, v19, v12
    v_mul_f32 v19, s52, v19
    v_add_f32 v20, v20, v12
    v_mul_f32 v20, s52, v20
    v_add_f32 v21, v21, v12
    v_mul_f32 v21, s52, v21
    v_add_f32 v22, v22, v12
    v_mul_f32 v22, s52, v22
    v_add_f32 v23, v23, v12
    v_mul_f32 v23, s52, v23
    v_add_f32 v24, v24, v12
    v_mul_f32 v24, s52, v24
    v_add_f32 v25, v25, v12
    v_mul_f32 v25, s52, v25
    v_add_f32 v26, v26, v12
    v_mul_f32 v26, s52, v26
    v_add_f32 v27, v27, v12
    v_mul_f32 v27, s52, v27
    v_add_f32 v28, v28, v12
    v_mul_f32 v28, s52, v28
    v_add_f32 v29, v29, v12
    v_mul_f32 v29, s52, v29
    v_add_f32 v30, v30, v12
    v_mul_f32 v30, s52, v30
    v_add_f32 v31, v31, v12
    v_mul_f32 v31, s52, v31
    s_mov_b32 s54, 0
    buffer_store_dword v16, v11, s[40:43], s54 offen
    s_mov_b32 s54, 1024
    buffer_store_dword v17, v11, s[40:43], s54 offen
    s_mov_b32 s54, 2048
    buffer_store_dword v18, v11, s[40:43], s54 offen
    s_mov_b32 s54, 3072
    buffer_store_dword v19, v11, s[40:43], s54 offen
    s_mov_b32 s54, 8192
    buffer_store_dword v20, v11, s[40:43], s54 offen
    s_mov_b32 s54, 9216
    buffer_store_dword v21, v11, s[40:43], s54 offen
    s_mov_b32 s54, 10240
    buffer_store_dword v22, v11, s[40:43], s54 offen
    s_mov_b32 s54, 11264
    buffer_store_dword v23, v11, s[40:43], s54 offen
    s_mov_b32 s54, 16384
    buffer_store_dword v24, v11, s[40:43], s54 offen
    s_mov_b32 s54, 17408
    buffer_store_dword v25, v11, s[40:43], s54 offen
    s_mov_b32 s54, 18432
    buffer_store_dword v26, v11, s[40:43], s54 offen
    s_mov_b32 s54, 19456
    buffer_store_dword v27, v11, s[40:43], s54 offen
    s_mov_b32 s54, 24576
    buffer_store_dword v28, v11, s[40:43], s54 offen
    s_mov_b32 s54, 25600
    buffer_store_dword v29, v11, s[40:43], s54 offen
    s_mov_b32 s54, 26624
    buffer_store_dword v30, v11, s[40:43], s54 offen
    s_mov_b32 s54, 27648
    buffer_store_dword v31, v11, s[40:43], s54 offen
Lp_next1:
    s_endpgm
Lp_tr:
    s_add_u32 s28, s16, 0
    s_addc_u32 s29, s17, 0
    s_mov_b32 s30, 65536
    s_mov_b32 s31, 0x20000
    s_add_u32 s32, s24, 19230720
    s_addc_u32 s33, s25, 0
    s_mov_b32 s34, 65536
    s_mov_b32 s35, 0x20000
    v_and_b32 v1, 127, v0
    v_lshrrev_b32 v2, 7, v0
    v_lshlrev_b32 v3, 13, v2
    v_lshl_add_u32 v3, v1, 1, v3
    s_mov_b32 s50, 0
    buffer_load_ushort v16, v3, s[28:31], s50 offen offset:0
    buffer_load_ushort v17, v3, s[28:31], s50 offen offset:256
    buffer_load_ushort v18, v3, s[28:31], s50 offen offset:512
    buffer_load_ushort v19, v3, s[28:31], s50 offen offset:768
    buffer_load_ushort v20, v3, s[28:31], s50 offen offset:1024
    buffer_load_ushort v21, v3, s[28:31], s50 offen offset:1280
    buffer_load_ushort v22, v3, s[28:31], s50 offen offset:1536
    buffer_load_ushort v23, v3, s[28:31], s50 offen offset:1792
    buffer_load_ushort v24, v3, s[28:31], s50 offen offset:2048
    buffer_load_ushort v25, v3, s[28:31], s50 offen offset:2304
    buffer_load_ushort v26, v3, s[28:31], s50 offen offset:2560
    buffer_load_ushort v27, v3, s[28:31], s50 offen offset:2816
    buffer_load_ushort v28, v3, s[28:31], s50 offen offset:3072
    buffer_load_ushort v29, v3, s[28:31], s50 offen offset:3328
    buffer_load_ushort v30, v3, s[28:31], s50 offen offset:3584
    buffer_load_ushort v31, v3, s[28:31], s50 offen offset:3840
    s_mov_b32 s50, 4096
    buffer_load_ushort v32, v3, s[28:31], s50 offen offset:0
    buffer_load_ushort v33, v3, s[28:31], s50 offen offset:256
    buffer_load_ushort v34, v3, s[28:31], s50 offen offset:512
    buffer_load_ushort v35, v3, s[28:31], s50 offen offset:768
    buffer_load_ushort v36, v3, s[28:31], s50 offen offset:1024
    buffer_load_ushort v37, v3, s[28:31], s50 offen offset:1280
    buffer_load_ushort v38, v3, s[28:31], s50 offen offset:1536
    buffer_load_ushort v39, v3, s[28:31], s50 offen offset:1792
    buffer_load_ushort v40, v3, s[28:31], s50 offen offset:2048
    buffer_load_ushort v41, v3, s[28:31], s50 offen offset:2304
    buffer_load_ushort v42, v3, s[28:31], s50 offen offset:2560
    buffer_load_ushort v43, v3, s[28:31], s50 offen offset:2816
    buffer_load_ushort v44, v3, s[28:31], s50 offen offset:3072
    buffer_load_ushort v45, v3, s[28:31], s50 offen offset:3328
    buffer_load_ushort v46, v3, s[28:31], s50 offen offset:3584
    buffer_load_ushort v47, v3, s[28:31], s50 offen offset:3840
    v_lshlrev_b32 v4, 9, v1
    v_lshl_add_u32 v4, v2, 6, v4
    s_waitcnt vmcnt(0)
    v_lshl_or_b32 v16, v17, 16, v16
    v_lshl_or_b32 v17, v19, 16, v18
    v_lshl_or_b32 v18, v21, 16, v20
    v_lshl_or_b32 v19, v23, 16, v22
    v_lshl_or_b32 v20, v25, 16, v24
    v_lshl_or_b32 v21, v27, 16, v26
    v_lshl_or_b32 v22, v29, 16, v28
    v_lshl_or_b32 v23, v31, 16, v30
    v_lshl_or_b32 v24, v33, 16, v32
    v_lshl_or_b32 v25, v35, 16, v34
    v_lshl_or_b32 v26, v37, 16, v36
    v_lshl_or_b32 v27, v39, 16, v38
    v_lshl_or_b32 v28, v41, 16, v40
    v_lshl_or_b32 v29, v43, 16, v42
    v_lshl_or_b32 v30, v45, 16, v44
    v_lshl_or_b32 v31, v47, 16, v46
    buffer_store_dwordx4 v[16:19], v4, s[32:35], 0 offen offset:0
    buffer_store_dwordx4 v[20:23], v4, s[32:35], 0 offen offset:16
    buffer_store_dwordx4 v[24:27], v4, s[32:35], 0 offen offset:32
    buffer_store_dwordx4 v[28:31], v4, s[32:35], 0 offen offset:48
    s_endpgm
Lp_sort:
    s_add_u32 s28, s10, 0
    s_addc_u32 s29, s11, 0
    s_mov_b32 s30, 1280000
    s_mov_b32 s31, 0x20000
    s_add_u32 s32, s8, 0
    s_addc_u32 s33, s9, 0
    s_mov_b32 s34, 1280000
    s_mov_b32 s35, 0x20000
    s_add_u32 s36, s6, 0
    s_addc_u32 s37, s7, 0
    s_mov_b32 s38, 640000
    s_mov_b32 s39, 0x20000
    s_add_u32 s40, s24, 15360000
    s_addc_u32 s41, s25, 0
    s_mov_b32 s42, 2560000
    s_mov_b32 s43, 0x20000
    s_add_u32 s44, s24, 17920000
    s_addc_u32 s45, s25, 0
    s_mov_b32 s46, 1310720
    s_mov_b32 s47, 0x20000
    v_mov_b32 v100, 0
    v_mov_b32 v101, 0
    v_mul_u32_u24 v1, 40, v0
    v_cmp_gt_u32 vcc, 1000, v0
    s_and_saveexec_b64 s[60:61], vcc
    ds_write_b64 v1, v[100:101] offset:0
    ds_write_b64 v1, v[100:101] offset:8
    ds_write_b64 v1, v[100:101] offset:16
    ds_write_b64 v1, v[100:101] offset:24
    ds_write_b64 v1, v[100:101] offset:32
    s_mov_b64 exec, s[60:61]
    s_mul_i32 s50, s2, 40000
    v_lshlrev_b32 v2, 2, v0
    v_lshlrev_b32 v3, 1, v0
    v_cmp_gt_u32 vcc, 784, v0
    s_mov_b64 s[62:63], vcc
    s_add_u32 s51, s50, 0
    buffer_load_dword v20, v2, s[28:31], s51 offen
    s_add_u32 s51, s50, 4096
    buffer_load_dword v21, v2, s[28:31], s51 offen
    s_add_u32 s51, s50, 8192
    buffer_load_dword v22, v2, s[28:31], s51 offen
    s_add_u32 s51, s50, 12288
    buffer_load_dword v23, v2, s[28:31], s51 offen
    s_add_u32 s51, s50, 16384
    buffer_load_dword v24, v2, s[28:31], s51 offen
    s_add_u32 s51, s50, 20480
    buffer_load_dword v25, v2, s[28:31], s51 offen
    s_add_u32 s51, s50, 24576
    buffer_load_dword v26, v2, s[28:31], s51 offen
    s_add_u32 s51, s50, 28672
    buffer_load_dword v27, v2, s[28:31], s51 offen
    s_add_u32 s51, s50, 32768
    buffer_load_dword v28, v2, s[28:31], s51 offen
    s_add_u32 s51, s50, 36864
    s_mov_b64 exec, s[62:63]
    buffer_load_dword v29, v2, s[28:31], s51 offen
    s_mov_b64 exec, -1
    v_mov_b32 v5, 1
    s_waitcnt lgkmcnt(0)
    s_barrier
    s_waitcnt vmcnt(9)
    v_lshlrev_b32 v20, 2, v20
    ds_add_rtn_u32 v40, v20, v5
    s_waitcnt vmcnt(8)
    v_lshlrev_b32 v21, 2, v21
    ds_add_rtn_u32 v41, v21, v5
    s_waitcnt vmcnt(7)
    v_lshlrev_b32 v22, 2, v22
    ds_add_rtn_u32 v42, v22, v5
    s_waitcnt vmcnt(6)
    v_lshlrev_b32 v23, 2, v23
    ds_add_rtn_u32 v43, v23, v5
    s_waitcnt vmcnt(5)
    v_lshlrev_b32 v24, 2, v24
    ds_add_rtn_u32 v44, v24, v5
    s_waitcnt vmcnt(4)
    v_lshlrev_b32 v25, 2, v25
    ds_add_rtn_u32 v45, v25, v5
    s_waitcnt vmcnt(3)
    v_lshlrev_b32 v26, 2, v26
    ds_add_rtn_u32 v46, v26, v5
    s_waitcnt vmcnt(2)
    v_lshlrev_b32 v27, 2, v27
    ds_add_rtn_u32 v47, v27, v5
    s_waitcnt vmcnt(1)
    v_lshlrev_b32 v28, 2, v28
    ds_add_rtn_u32 v48, v28, v5
    s_waitcnt vmcnt(0)
    v_lshlrev_b32 v29, 2, v29
    s_mov_b64 exec, s[62:63]
    ds_add_rtn_u32 v49, v29, v5
    s_mov_b64 exec, -1
    s_lshr_b32 s52, s50, 1
    s_add_u32 s51, s50, 0
    s_add_u32 s53, s52, 0
    buffer_load_dword v30, v2, s[32:35], s51 offen
    buffer_load_ushort v80, v3, s[36:39], s53 offen
    s_add_u32 s51, s50, 4096
    s_add_u32 s53, s52, 2048
    buffer_load_dword v31, v2, s[32:35], s51 offen
    buffer_load_ushort v81, v3, s[36:39], s53 offen
    s_add_u32 s51, s50, 8192
    s_add_u32 s53, s52, 4096
    buffer_load_dword v32, v2, s[32:35], s51 offen
    buffer_load_ushort v82, v3, s[36:39], s53 offen
    s_add_u32 s51, s50, 12288
    s_add_u32 s53, s52, 6144
    buffer_load_dword v33, v2, s[32:35], s51 offen
    buffer_load_ushort v83, v3, s[36:39], s53 offen
    s_add_u32 s51, s50, 16384
    s_add_u32 s53, s52, 8192
    buffer_load_dword v34, v2, s[32:35], s51 offen
    buffer_load_ushort v84, v3, s[36:39], s53 offen
    s_add_u32 s51, s50, 20480
    s_add_u32 s53, s52, 10240
    buffer_load_dword v35, v2, s[32:35], s51 offen
    buffer_load_ushort v85, v3, s[36:39], s53 offen
    s_add_u32 s51, s50, 24576
    s_add_u32 s53, s52, 12288
    buffer_load_dword v36, v2, s[32:35], s51 offen
    buffer_load_ushort v86, v3, s[36:39], s53 offen
    s_add_u32 s51, s50, 28672
    s_add_u32 s53, s52, 14336
    buffer_load_dword v37, v2, s[32:35], s51 offen
    buffer_load_ushort v87, v3, s[36:39], s53 offen
    s_add_u32 s51, s50, 32768
    s_add_u32 s53, s52, 16384
    buffer_load_dword v38, v2, s[32:35], s51 offen
    buffer_load_ushort v88, v3, s[36:39], s53 offen
    s_add_u32 s51, s50, 36864
    s_add_u32 s53, s52, 18432
    s_mov_b64 exec, s[62:63]
    buffer_load_dword v39, v2, s[32:35], s51 offen
    buffer_load_ushort v89, v3, s[36:39], s53 offen
    s_mov_b64 exec, -1
    s_waitcnt lgkmcnt(0)
    s_barrier
    v_mov_b32 v6, 0
    v_cmp_gt_u32 vcc, 1000, v0
    s_and_saveexec_b64 s[60:61], vcc
    ds_read_b64 v[100:101], v1 offset:0
    ds_read_b64 v[102:103], v1 offset:8
    ds_read_b64 v[104:105], v1 offset:16
    ds_read_b64 v[106:107], v1 offset:24
    ds_read_b64 v[108:109], v1 offset:32
    s_waitcnt lgkmcnt(0)
    v_mov_b32 v7, v100
    v_mov_b32 v100, v6
    v_add_u32 v6, v6, v7
    v_mov_b32 v7, v101
    v_mov_b32 v101, v6
    v_add_u32 v6, v6, v7
    v_mov_b32 v7, v102
    v_mov_b32 v102, v6
    v_add_u32 v6, v6, v7
    v_mov_b32 v7, v103
    v_mov_b32 v103, v6
    v_add_u32 v6, v6, v7
    v_mov_b32 v7, v104
    v_mov_b32 v104, v6
    v_add_u32 v6, v6, v7
    v_mov_b32 v7, v105
    v_mov_b32 v105, v6
    v_add_u32 v6, v6, v7
    v_mov_b32 v7, v106
    v_mov_b32 v106, v6
    v_add_u32 v6, v6, v7
    v_mov_b32 v7, v107
    v_mov_b32 v107, v6
    v_add_u32 v6, v6, v7
    v_mov_b32 v7, v108
    v_mov_b32 v108, v6
    v_add_u32 v6, v6, v7
    v_mov_b32 v7, v109
    v_mov_b32 v109, v6
    v_add_u32 v6, v6, v7
    s_mov_b64 exec, s[60:61]
    v_mov_b32 v8, v6
    s_nop 1
    v_add_u32_dpp v8, v8, v8 row_shr:1 row_mask:0xf bank_mask:0xf bound_ctrl:0
    s_nop 1
    v_add_u32_dpp v8, v8, v8 row_shr:2 row_mask:0xf bank_mask:0xf bound_ctrl:0
    s_nop 1
    v_add_u32_dpp v8, v8, v8 row_shr:4 row_mask:0xf bank_mask:0xf bound_ctrl:0
    s_nop 1
    v_add_u32_dpp v8, v8, v8 row_shr:8 row_mask:0xf bank_mask:0xf bound_ctrl:0
    s_nop 1
    v_add_u32_dpp v8, v8, v8 row_bcast:15 row_mask:0xa bank_mask:0xf
    s_nop 1
    v_add_u32_dpp v8, v8, v8 row_bcast:31 row_mask:0xc bank_mask:0xf
    v_lshrrev_b32 v9, 6, v0
    v_lshlrev_b32 v10, 2, v9
    v_and_b32 v11, 63, v0
    v_cmp_eq_u32 vcc, 63, v11
    s_and_saveexec_b64 s[60:61], vcc
    ds_write_b32 v10, v8 offset:40000
    s_mov_b64 exec, s[60:61]
    v_sub_u32 v8, v8, v6
    s_waitcnt lgkmcnt(0)
    s_barrier
    v_and_b32 v12, 15, v0
    v_lshlrev_b32 v13, 2, v12
    ds_read_b32 v14, v13 offset:40000
    v_cmp_gt_u32 vcc, v9, v12
    s_waitcnt lgkmcnt(0)
    v_cndmask_b32 v14, 0, v14, vcc
    s_nop 1
    v_add_u32_dpp v14, v14, v14 row_shr:1 row_mask:0xf bank_mask:0xf bound_ctrl:0
    s_nop 1
    v_add_u32_dpp v14, v14, v14 row_shr:2 row_mask:0xf bank_mask:0xf bound_ctrl:0
    s_nop 1
    v_add_u32_dpp v14, v14, v14 row_shr:4 row_mask:0xf bank_mask:0xf bound_ctrl:0
    s_nop 1
    v_add_u32_dpp v14, v14, v14 row_shr:8 row_mask:0xf bank_mask:0xf bound_ctrl:0
    s_nop 1
    v_readlane_b32 s54, v14, 15
    s_nop 3
    v_add_u32 v8, s54, v8
    s_mul_i32 s55, s2, 10000
    v_cmp_gt_u32 vcc, 1000, v0
    s_and_saveexec_b64 s[60:61], vcc
    v_add_u32 v100, v100, v8
    v_add_u32 v101, v101, v8
    v_add_u32 v102, v102, v8
    v_add_u32 v103, v103, v8
    v_add_u32 v104, v104, v8
    v_add_u32 v105, v105, v8
    v_add_u32 v106, v106, v8
    v_add_u32 v107, v107, v8
    v_add_u32 v108, v108, v8
    v_add_u32 v109, v109, v8
    ds_write_b64 v1, v[100:101] offset:0
    ds_write_b64 v1, v[102:103] offset:8
    ds_write_b64 v1, v[104:105] offset:16
    ds_write_b64 v1, v[106:107] offset:24
    ds_write_b64 v1, v[108:109] offset:32
    s_mul_i32 s56, s2, 40960
    v_add_u32 v100, s55, v100
    v_add_u32 v101, s55, v101
    buffer_store_dwordx2 v[100:101], v1, s[44:47], s56 offen offset:0
    v_add_u32 v102, s55, v102
    v_add_u32 v103, s55, v103
    buffer_store_dwordx2 v[102:103], v1, s[44:47], s56 offen offset:8
    v_add_u32 v104, s55, v104
    v_add_u32 v105, s55, v105
    buffer_store_dwordx2 v[104:105], v1, s[44:47], s56 offen offset:16
    v_add_u32 v106, s55, v106
    v_add_u32 v107, s55, v107
    buffer_store_dwordx2 v[106:107], v1, s[44:47], s56 offen offset:24
    v_add_u32 v108, s55, v108
    v_add_u32 v109, s55, v109
    buffer_store_dwordx2 v[108:109], v1, s[44:47], s56 offen offset:32
    s_mov_b64 exec, s[60:61]
    s_add_u32 s57, s55, 10000
    v_mov_b32 v16, s57
    v_mov_b32 v17, 40000
    v_cmp_eq_u32 vcc, 0, v0
    s_and_saveexec_b64 s[60:61], vcc
    buffer_store_dword v16, v17, s[44:47], s56 offen
    s_mov_b64 exec, s[60:61]
    s_waitcnt lgkmcnt(0)
    s_barrier
    ds_read_b32 v100, v20
    ds_read_b32 v101, v21
    ds_read_b32 v102, v22
    ds_read_b32 v103, v23
    ds_read_b32 v104, v24
    ds_read_b32 v105, v25
    ds_read_b32 v106, v26
    ds_read_b32 v107, v27
    ds_read_b32 v108, v28
    s_mov_b64 exec, s[62:63]
    ds_read_b32 v109, v29
    s_mov_b64 exec, -1
    s_waitcnt vmcnt(0)
    s_waitcnt lgkmcnt(9)
    v_add_lshl_u32 v100, v100, v40, 3
    v_lshlrev_b32 v60, 9, v30
    v_lshlrev_b32 v61, 16, v80
    ds_write_b64 v100, v[60:61] offset:40320
    s_waitcnt lgkmcnt(8)
    v_add_lshl_u32 v101, v101, v41, 3
    v_lshlrev_b32 v62, 9, v31
    v_lshlrev_b32 v63, 16, v81
    ds_write_b64 v101, v[62:63] offset:40320
    s_waitcnt lgkmcnt(7)
    v_add_lshl_u32 v102, v102, v42, 3
    v_lshlrev_b32 v64, 9, v32
    v_lshlrev_b32 v65, 16, v82
    ds_write_b64 v102, v[64:65] offset:40320
    s_waitcnt lgkmcnt(6)
    v_add_lshl_u32 v103, v103, v43, 3
    v_lshlrev_b32 v66, 9, v33
    v_lshlrev_b32 v67, 16, v83
    ds_write_b64 v103, v[66:67] offset:40320
    s_waitcnt lgkmcnt(5)
    v_add_lshl_u32 v104, v104, v44, 3
    v_lshlrev_b32 v68, 9, v34
    v_lshlrev_b32 v69, 16, v84
    ds_write_b64 v104, v[68:69] offset:40320
    s_waitcnt lgkmcnt(4)
    v_add_lshl_u32 v105, v105, v45, 3
    v_lshlrev_b32 v70, 9, v35
    v_lshlrev_b32 v71, 16, v85
    ds_write_b64 v105, v[70:71] offset:40320
    s_waitcnt lgkmcnt(3)
    v_add_lshl_u32 v106, v106, v46, 3
    v_lshlrev_b32 v72, 9, v36
    v_lshlrev_b32 v73, 16, v86
    ds_write_b64 v106, v[72:73] offset:40320
    s_waitcnt lgkmcnt(2)
    v_add_lshl_u32 v107, v107, v47, 3
    v_lshlrev_b32 v74, 9, v37
    v_lshlrev_b32 v75, 16, v87
    ds_write_b64 v107, v[74:75] offset:40320
    s_waitcnt lgkmcnt(1)
    v_add_lshl_u32 v108, v108, v48, 3
    v_lshlrev_b32 v76, 9, v38
    v_lshlrev_b32 v77, 16, v88
    ds_write_b64 v108, v[76:77] offset:40320
    s_waitcnt lgkmcnt(0)
    v_add_lshl_u32 v109, v109, v49, 3
    v_lshlrev_b32 v78, 9, v39
    v_lshlrev_b32 v79, 16, v89
    s_mov_b64 exec, s[62:63]
    ds_write_b64 v109, v[78:79] offset:40320
    s_mov_b64 exec, -1
    s_waitcnt lgkmcnt(0)
    s_barrier
    v_lshlrev_b32 v2, 4, v0
    s_mul_i32 s56, s2, 80000
    v_add_u32 v3, 40320, v2
    v_add_u32 v4, 0x8000, v3
    v_add_u32 v5, 0x8000, v4
    v_cmp_gt_u32 vcc, 904, v0
    s_mov_b64 s[62:63], vcc
    ds_read_b128 v[60:63], v3 offset:0
    ds_read_b128 v[64:67], v3 offset:16384
    ds_read_b128 v[68:71], v4 offset:0
    ds_read_b128 v[72:75], v4 offset:16384
    s_mov_b64 exec, s[62:63]
    ds_read_b128 v[76:79], v5 offset:0
    s_mov_b64 exec, -1
    s_waitcnt lgkmcnt(4)
    s_add_u32 s57, s56, 0
    buffer_store_dwordx4 v[60:63], v2, s[40:43], s57 offen
    s_waitcnt lgkmcnt(3)
    s_add_u32 s57, s56, 16384
    buffer_store_dwordx4 v[64:67], v2, s[40:43], s57 offen
    s_waitcnt lgkmcnt(2)
    s_add_u32 s57, s56, 32768
    buffer_store_dwordx4 v[68:71], v2, s[40:43], s57 offen
    s_waitcnt lgkmcnt(1)
    s_add_u32 s57, s56, 49152
    buffer_store_dwordx4 v[72:75], v2, s[40:43], s57 offen
    s_waitcnt lgkmcnt(0)
    s_add_u32 s57, s56, 65536
    s_mov_b64 exec, s[62:63]
    buffer_store_dwordx4 v[76:79], v2, s[40:43], s57 offen
Lp_end:
    s_endpgm
.globl main_kernel
.p2align 8
.type main_kernel,@function
main_kernel:
    s_cmp_ge_u32 s2, 256
    s_cbranch_scc1 Lm_end
    s_load_dwordx16 s[4:19], s[0:1], 0
    s_load_dwordx4 s[20:23], s[0:1], 64
    s_load_dwordx2 s[24:25], s[0:1], 80
    s_waitcnt lgkmcnt(0)
    s_add_u32 s28, s24, 0
    s_addc_u32 s29, s25, 0
    s_mov_b32 s30, 5120000
    s_mov_b32 s31, 0x20000
    s_add_u32 s32, s24, 5120000
    s_addc_u32 s33, s25, 0
    s_mov_b32 s34, 10240000
    s_mov_b32 s35, 0x20000
    s_add_u32 s36, s24, 15360000
    s_addc_u32 s37, s25, 0
    s_mov_b32 s38, 2560000
    s_mov_b32 s39, 0x20000
    s_add_u32 s40, s24, 17920000
    s_addc_u32 s41, s25, 0
    s_mov_b32 s42, 1310720
    s_mov_b32 s43, 0x20000
    s_add_u32 s44, s24, 19230720
    s_addc_u32 s45, s25, 0
    s_mov_b32 s46, 65536
    s_mov_b32 s47, 0x20000
    s_add_u32 s48, s20, 0
    s_addc_u32 s49, s21, 0
    s_mov_b32 s50, 2560000
    s_mov_b32 s51, 0x20000
    s_add_u32 s52, s12, 0
    s_addc_u32 s53, s13, 0
    s_mov_b32 s54, 131584
    s_mov_b32 s55, 0x20000
    s_add_u32 s56, s18, 0
    s_addc_u32 s57, s19, 0
    s_mov_b32 s58, 256
    s_mov_b32 s59, 0x20000
    s_mul_i32 s60, s2, 625
    s_lshr_b32 s60, s60, 4
    s_add_u32 s61, s2, 1
    s_mul_i32 s61, s61, 625
    s_lshr_b32 s61, s61, 4
    s_sub_u32 s61, s61, s60
    v_and_b32 v1, 63, v0
    v_lshlrev_b32 v2, 3, v1
    v_lshlrev_b32 v3, 4, v1
    v_lshlrev_b32 v4, 2, v1
    s_mov_b32 s62, 131072
    buffer_load_dwordx2 v[6:7], v2, s[52:55], s62 offen
    v_mov_b32 v8, 0
    v_mov_b32 v9, 25536
    v_cmp_eq_u32 vcc, 0, v0
    s_and_saveexec_b64 s[64:65], vcc
    ds_write_b32 v9, v8
    s_mov_b64 exec, s[64:65]
    s_mov_b32 s63, 0xbfb8aa3b
    s_waitcnt vmcnt(0) lgkmcnt(0)
    v_lshlrev_b32 v10, 16, v6
    v_and_b32 v11, 0xffff0000, v6
    v_lshlrev_b32 v12, 16, v7
    v_and_b32 v13, 0xffff0000, v7
    v_mul_f32 v10, s63, v10
    v_mul_f32 v11, s63, v11
    v_mul_f32 v12, s63, v12
    v_mul_f32 v13, s63, v13
    v_mov_b32 v8, 1
    s_barrier
    v_lshrrev_b32 v5, 6, v0
    v_lshl_add_u32 v60, v5, 9, v2
    v_add_u32 v60, 25600, v60
    v_lshlrev_b32 v61, 9, v5
    v_add_u32 v61, 25600, v61
    v_mul_u32_u24 v62, 40960, v1
    v_mov_b32 v56, 1.0
    v_mov_b32 v57, 1.0
    s_mov_b64 exec, 1
    ds_add_rtn_u32 v14, v9, v8
    s_waitcnt lgkmcnt(0)
    v_readfirstlane_b32 s100, v14
    s_mov_b64 exec, -1
    s_add_u32 s67, s60, s100
    s_lshl_b32 s68, s67, 2
    buffer_load_dwordx2 v[76:77], v62, s[40:43], s68 offen
    s_lshl_b32 s68, s67, 10
    buffer_load_dwordx4 v[80:83], v3, s[32:35], s68 offen
Lm_node:
    s_mov_b32 s66, s100
    s_cmp_ge_u32 s66, s61
    s_cbranch_scc1 Lm_done
    s_waitcnt vmcnt(0)
    v_mov_b32 v28, v76
    v_mov_b32 v29, v77
    v_mov_b32 v16, v80
    v_mov_b32 v17, v81
    v_mov_b32 v18, v82
    v_mov_b32 v19, v83
    v_sub_u32 v29, v29, v28
    v_cmp_gt_u32 vcc, 32, v1
    s_nop 1
    v_cndmask_b32 v29, 0, v29, vcc
    v_lshlrev_b32 v28, 3, v28
    v_cmp_lt_u32 vcc, 0, v29
    s_nop 3
    s_mov_b64 exec, vcc
    buffer_load_dwordx2 v[64:65], v28, s[36:39], 0 offen offset:0
    v_cmp_lt_u32 vcc, 1, v29
    s_nop 3
    s_mov_b64 exec, vcc
    buffer_load_dwordx2 v[66:67], v28, s[36:39], 0 offen offset:8
    v_cmp_lt_u32 vcc, 2, v29
    s_nop 3
    s_mov_b64 exec, vcc
    buffer_load_dwordx2 v[68:69], v28, s[36:39], 0 offen offset:16
    v_cmp_lt_u32 vcc, 3, v29
    s_nop 3
    s_mov_b64 exec, vcc
    buffer_load_dwordx2 v[70:71], v28, s[36:39], 0 offen offset:24
    s_mov_b64 exec, -1
    s_mov_b64 exec, 1
    ds_add_rtn_u32 v14, v9, v8
    s_waitcnt lgkmcnt(0)
    v_readfirstlane_b32 s100, v14
    s_mov_b64 exec, -1
    s_add_u32 s67, s60, s100
    s_lshl_b32 s68, s67, 2
    buffer_load_dwordx2 v[76:77], v62, s[40:43], s68 offen
    s_lshl_b32 s68, s67, 10
    buffer_load_dwordx4 v[80:83], v3, s[32:35], s68 offen
    v_mov_b32 v20, 0
    v_mov_b32 v21, 0
    v_mov_b32 v22, 0
    v_mov_b32 v23, 0
    s_mov_b32 s71, 0
    s_mov_b32 s70, 0
    s_mov_b32 s69, 0
    s_waitcnt vmcnt(2)
    v_cmp_lt_u32 vcc, 0, v29
    s_cbranch_vccz Lm_last
    v_mbcnt_lo_u32_b32 v30, vcc_lo, 0
    v_mbcnt_hi_u32_b32 v30, vcc_hi, v30
    v_add_lshl_u32 v30, v30, s69, 3
    v_add_u32 v30, v30, v61
    s_bcnt1_i32_b64 s72, vcc
    s_mov_b64 exec, vcc
    ds_write_b64 v30, v[64:65]
    s_mov_b64 exec, -1
    s_add_u32 s69, s69, s72
    s_add_u32 s71, s71, s72
    s_cmp_le_u32 s69, 32
    s_cbranch_scc1 Lm_r0
    s_getpc_b64 s[80:81]
    s_add_u32 s80, s80, 12
    s_addc_u32 s81, s81, 0
    s_branch Lm_batch
    s_mov_b32 s69, 0
Lm_r0:
    v_cmp_lt_u32 vcc, 1, v29
    s_cbranch_vccz Lm_last
    v_mbcnt_lo_u32_b32 v30, vcc_lo, 0
    v_mbcnt_hi_u32_b32 v30, vcc_hi, v30
    v_add_lshl_u32 v30, v30, s69, 3
    v_add_u32 v30, v30, v61
    s_bcnt1_i32_b64 s72, vcc
    s_mov_b64 exec, vcc
    ds_write_b64 v30, v[66:67]
    s_mov_b64 exec, -1
    s_add_u32 s69, s69, s72
    s_add_u32 s71, s71, s72
    s_cmp_le_u32 s69, 32
    s_cbranch_scc1 Lm_r1
    s_getpc_b64 s[80:81]
    s_add_u32 s80, s80, 12
    s_addc_u32 s81, s81, 0
    s_branch Lm_batch
    s_mov_b32 s69, 0
Lm_r1:
    v_cmp_lt_u32 vcc, 2, v29
    s_cbranch_vccz Lm_last
    v_mbcnt_lo_u32_b32 v30, vcc_lo, 0
    v_mbcnt_hi_u32_b32 v30, vcc_hi, v30
    v_add_lshl_u32 v30, v30, s69, 3
    v_add_u32 v30, v30, v61
    s_bcnt1_i32_b64 s72, vcc
    s_mov_b64 exec, vcc
    ds_write_b64 v30, v[68:69]
    s_mov_b64 exec, -1
    s_add_u32 s69, s69, s72
    s_add_u32 s71, s71, s72
    s_cmp_le_u32 s69, 32
    s_cbranch_scc1 Lm_r2
    s_getpc_b64 s[80:81]
    s_add_u32 s80, s80, 12
    s_addc_u32 s81, s81, 0
    s_branch Lm_batch
    s_mov_b32 s69, 0
Lm_r2:
    v_cmp_lt_u32 vcc, 3, v29
    s_cbranch_vccz Lm_last
    v_mbcnt_lo_u32_b32 v30, vcc_lo, 0
    v_mbcnt_hi_u32_b32 v30, vcc_hi, v30
    v_add_lshl_u32 v30, v30, s69, 3
    v_add_u32 v30, v30, v61
    s_bcnt1_i32_b64 s72, vcc
    s_mov_b64 exec, vcc
    ds_write_b64 v30, v[70:71]
    s_mov_b64 exec, -1
    s_add_u32 s69, s69, s72
    s_add_u32 s71, s71, s72
    s_cmp_le_u32 s69, 32
    s_cbranch_scc1 Lm_r3
    s_getpc_b64 s[80:81]
    s_add_u32 s80, s80, 12
    s_addc_u32 s81, s81, 0
    s_branch Lm_batch
    s_mov_b32 s69, 0
Lm_r3:
    s_mov_b32 s70, 4
Lm_rg:
    v_cmp_lt_u32 vcc, s70, v29
    s_cbranch_vccz Lm_last
    s_lshl_b32 s72, s70, 3
    s_mov_b64 exec, vcc
    buffer_load_dwordx2 v[64:65], v28, s[36:39], s72 offen
    s_mov_b64 exec, -1
    s_waitcnt vmcnt(0)
    v_mbcnt_lo_u32_b32 v30, vcc_lo, 0
    v_mbcnt_hi_u32_b32 v30, vcc_hi, v30
    v_add_lshl_u32 v30, v30, s69, 3
    v_add_u32 v30, v30, v61
    s_bcnt1_i32_b64 s72, vcc
    s_mov_b64 exec, vcc
    ds_write_b64 v30, v[64:65]
    s_mov_b64 exec, -1
    s_add_u32 s69, s69, s72
    s_add_u32 s71, s71, s72
    s_add_u32 s70, s70, 1
    s_cmp_le_u32 s69, 32
    s_cbranch_scc1 Lm_rg
    s_getpc_b64 s[80:81]
    s_add_u32 s80, s80, 12
    s_addc_u32 s81, s81, 0
    s_branch Lm_batch
    s_mov_b32 s69, 0
    s_branch Lm_rg
Lm_last:
    s_getpc_b64 s[80:81]
    s_add_u32 s80, s80, 12
    s_addc_u32 s81, s81, 0
    s_branch Lm_batch
    s_mov_b32 s69, 0
    s_mov_b32 s68, 0xbf317218
    v_mul_f32 v20, s68, v20
    v_mul_f32 v21, s68, v21
    v_mul_f32 v22, s68, v22
    v_mul_f32 v23, s68, v23
    v_cvt_pk_bf16_f32 v20, v20, v21
    v_cvt_pk_bf16_f32 v21, v22, v23
    s_mul_i32 s68, s66, 528
    v_add_u32 v26, s68, v2
    ds_write_b64 v26, v[20:21]
    s_lshl_b32 s68, s66, 2
    v_mov_b32 v26, s68
    v_mov_b32 v27, s71
    ds_write_b32 v26, v27 offset:25344
    s_branch Lm_node
Lm_batch:
    s_cmp_eq_u32 s69, 0
    s_cbranch_scc1 Lm_ret
    s_waitcnt lgkmcnt(0)
    ds_read_b64 v[24:25], v60
    s_sub_u32 s73, s69, 1
    s_waitcnt lgkmcnt(0)
    s_min_u32 s83, 0, s73
    v_readlane_b32 s85, v24, s83
    v_readlane_b32 s84, v25, s83
    s_min_u32 s83, 1, s73
    v_readlane_b32 s87, v24, s83
    v_readlane_b32 s86, v25, s83
    s_min_u32 s83, 2, s73
    v_readlane_b32 s89, v24, s83
    v_readlane_b32 s88, v25, s83
    s_min_u32 s83, 3, s73
    v_readlane_b32 s91, v24, s83
    v_readlane_b32 s90, v25, s83
    s_min_u32 s83, 4, s73
    v_readlane_b32 s93, v24, s83
    v_readlane_b32 s92, v25, s83
    s_min_u32 s83, 5, s73
    v_readlane_b32 s95, v24, s83
    v_readlane_b32 s94, v25, s83
    s_min_u32 s83, 6, s73
    v_readlane_b32 s97, v24, s83
    v_readlane_b32 s96, v25, s83
    s_min_u32 s83, 7, s73
    v_readlane_b32 s99, v24, s83
    v_readlane_b32 s98, v25, s83
    s_nop 4
    buffer_load_dwordx2 v[32:33], v2, s[28:31], s85 offen
    buffer_load_dwordx2 v[34:35], v2, s[28:31], s87 offen
    buffer_load_dwordx2 v[36:37], v2, s[28:31], s89 offen
    buffer_load_dwordx2 v[38:39], v2, s[28:31], s91 offen
    buffer_load_dwordx2 v[40:41], v2, s[28:31], s93 offen
    buffer_load_dwordx2 v[42:43], v2, s[28:31], s95 offen
    buffer_load_dwordx2 v[44:45], v2, s[28:31], s97 offen
    buffer_load_dwordx2 v[46:47], v2, s[28:31], s99 offen
    s_mov_b32 s82, 0
Lm_loop:
    s_waitcnt vmcnt(7)
    v_lshlrev_b32 v48, 16, v32
    v_and_b32 v49, 0xffff0000, v32
    v_lshlrev_b32 v50, 16, v33
    v_and_b32 v51, 0xffff0000, v33
    v_pk_fma_f32 v[52:53], s[84:85], v[10:11], v[16:17] op_sel_hi:[0,1,1]
    v_pk_fma_f32 v[54:55], s[84:85], v[12:13], v[18:19] op_sel_hi:[0,1,1]
    s_add_u32 s83, s82, 8
    s_min_u32 s83, s83, s73
    v_readlane_b32 s85, v24, s83
    v_readlane_b32 s84, v25, s83
    v_pk_add_f32 v[48:49], v[48:49], v[52:53]
    v_pk_add_f32 v[50:51], v[50:51], v[54:55]
    v_exp_f32 v52, v48
    v_exp_f32 v53, v49
    v_exp_f32 v54, v50
    v_exp_f32 v55, v51
    buffer_load_dwordx2 v[32:33], v2, s[28:31], s85 offen
    v_pk_add_f32 v[52:53], v[52:53], v[56:57]
    v_pk_add_f32 v[54:55], v[54:55], v[56:57]
    v_rcp_f32 v52, v52
    v_rcp_f32 v53, v53
    v_rcp_f32 v54, v54
    v_rcp_f32 v55, v55
    s_add_u32 s82, s82, 1
    v_pk_fma_f32 v[20:21], v[48:49], v[52:53], v[20:21]
    v_pk_fma_f32 v[22:23], v[50:51], v[54:55], v[22:23]
    s_cmp_ge_u32 s82, s69
    s_cbranch_scc1 Lm_ret
    s_waitcnt vmcnt(7)
    v_lshlrev_b32 v48, 16, v34
    v_and_b32 v49, 0xffff0000, v34
    v_lshlrev_b32 v50, 16, v35
    v_and_b32 v51, 0xffff0000, v35
    v_pk_fma_f32 v[52:53], s[86:87], v[10:11], v[16:17] op_sel_hi:[0,1,1]
    v_pk_fma_f32 v[54:55], s[86:87], v[12:13], v[18:19] op_sel_hi:[0,1,1]
    s_add_u32 s83, s82, 8
    s_min_u32 s83, s83, s73
    v_readlane_b32 s87, v24, s83
    v_readlane_b32 s86, v25, s83
    v_pk_add_f32 v[48:49], v[48:49], v[52:53]
    v_pk_add_f32 v[50:51], v[50:51], v[54:55]
    v_exp_f32 v52, v48
    v_exp_f32 v53, v49
    v_exp_f32 v54, v50
    v_exp_f32 v55, v51
    buffer_load_dwordx2 v[34:35], v2, s[28:31], s87 offen
    v_pk_add_f32 v[52:53], v[52:53], v[56:57]
    v_pk_add_f32 v[54:55], v[54:55], v[56:57]
    v_rcp_f32 v52, v52
    v_rcp_f32 v53, v53
    v_rcp_f32 v54, v54
    v_rcp_f32 v55, v55
    s_add_u32 s82, s82, 1
    v_pk_fma_f32 v[20:21], v[48:49], v[52:53], v[20:21]
    v_pk_fma_f32 v[22:23], v[50:51], v[54:55], v[22:23]
    s_cmp_ge_u32 s82, s69
    s_cbranch_scc1 Lm_ret
    s_waitcnt vmcnt(7)
    v_lshlrev_b32 v48, 16, v36
    v_and_b32 v49, 0xffff0000, v36
    v_lshlrev_b32 v50, 16, v37
    v_and_b32 v51, 0xffff0000, v37
    v_pk_fma_f32 v[52:53], s[88:89], v[10:11], v[16:17] op_sel_hi:[0,1,1]
    v_pk_fma_f32 v[54:55], s[88:89], v[12:13], v[18:19] op_sel_hi:[0,1,1]
    s_add_u32 s83, s82, 8
    s_min_u32 s83, s83, s73
    v_readlane_b32 s89, v24, s83
    v_readlane_b32 s88, v25, s83
    v_pk_add_f32 v[48:49], v[48:49], v[52:53]
    v_pk_add_f32 v[50:51], v[50:51], v[54:55]
    v_exp_f32 v52, v48
    v_exp_f32 v53, v49
    v_exp_f32 v54, v50
    v_exp_f32 v55, v51
    buffer_load_dwordx2 v[36:37], v2, s[28:31], s89 offen
    v_pk_add_f32 v[52:53], v[52:53], v[56:57]
    v_pk_add_f32 v[54:55], v[54:55], v[56:57]
    v_rcp_f32 v52, v52
    v_rcp_f32 v53, v53
    v_rcp_f32 v54, v54
    v_rcp_f32 v55, v55
    s_add_u32 s82, s82, 1
    v_pk_fma_f32 v[20:21], v[48:49], v[52:53], v[20:21]
    v_pk_fma_f32 v[22:23], v[50:51], v[54:55], v[22:23]
    s_cmp_ge_u32 s82, s69
    s_cbranch_scc1 Lm_ret
    s_waitcnt vmcnt(7)
    v_lshlrev_b32 v48, 16, v38
    v_and_b32 v49, 0xffff0000, v38
    v_lshlrev_b32 v50, 16, v39
    v_and_b32 v51, 0xffff0000, v39
    v_pk_fma_f32 v[52:53], s[90:91], v[10:11], v[16:17] op_sel_hi:[0,1,1]
    v_pk_fma_f32 v[54:55], s[90:91], v[12:13], v[18:19] op_sel_hi:[0,1,1]
    s_add_u32 s83, s82, 8
    s_min_u32 s83, s83, s73
    v_readlane_b32 s91, v24, s83
    v_readlane_b32 s90, v25, s83
    v_pk_add_f32 v[48:49], v[48:49], v[52:53]
    v_pk_add_f32 v[50:51], v[50:51], v[54:55]
    v_exp_f32 v52, v48
    v_exp_f32 v53, v49
    v_exp_f32 v54, v50
    v_exp_f32 v55, v51
    buffer_load_dwordx2 v[38:39], v2, s[28:31], s91 offen
    v_pk_add_f32 v[52:53], v[52:53], v[56:57]
    v_pk_add_f32 v[54:55], v[54:55], v[56:57]
    v_rcp_f32 v52, v52
    v_rcp_f32 v53, v53
    v_rcp_f32 v54, v54
    v_rcp_f32 v55, v55
    s_add_u32 s82, s82, 1
    v_pk_fma_f32 v[20:21], v[48:49], v[52:53], v[20:21]
    v_pk_fma_f32 v[22:23], v[50:51], v[54:55], v[22:23]
    s_cmp_ge_u32 s82, s69
    s_cbranch_scc1 Lm_ret
    s_waitcnt vmcnt(7)
    v_lshlrev_b32 v48, 16, v40
    v_and_b32 v49, 0xffff0000, v40
    v_lshlrev_b32 v50, 16, v41
    v_and_b32 v51, 0xffff0000, v41
    v_pk_fma_f32 v[52:53], s[92:93], v[10:11], v[16:17] op_sel_hi:[0,1,1]
    v_pk_fma_f32 v[54:55], s[92:93], v[12:13], v[18:19] op_sel_hi:[0,1,1]
    s_add_u32 s83, s82, 8
    s_min_u32 s83, s83, s73
    v_readlane_b32 s93, v24, s83
    v_readlane_b32 s92, v25, s83
    v_pk_add_f32 v[48:49], v[48:49], v[52:53]
    v_pk_add_f32 v[50:51], v[50:51], v[54:55]
    v_exp_f32 v52, v48
    v_exp_f32 v53, v49
    v_exp_f32 v54, v50
    v_exp_f32 v55, v51
    buffer_load_dwordx2 v[40:41], v2, s[28:31], s93 offen
    v_pk_add_f32 v[52:53], v[52:53], v[56:57]
    v_pk_add_f32 v[54:55], v[54:55], v[56:57]
    v_rcp_f32 v52, v52
    v_rcp_f32 v53, v53
    v_rcp_f32 v54, v54
    v_rcp_f32 v55, v55
    s_add_u32 s82, s82, 1
    v_pk_fma_f32 v[20:21], v[48:49], v[52:53], v[20:21]
    v_pk_fma_f32 v[22:23], v[50:51], v[54:55], v[22:23]
    s_cmp_ge_u32 s82, s69
    s_cbranch_scc1 Lm_ret
    s_waitcnt vmcnt(7)
    v_lshlrev_b32 v48, 16, v42
    v_and_b32 v49, 0xffff0000, v42
    v_lshlrev_b32 v50, 16, v43
    v_and_b32 v51, 0xffff0000, v43
    v_pk_fma_f32 v[52:53], s[94:95], v[10:11], v[16:17] op_sel_hi:[0,1,1]
    v_pk_fma_f32 v[54:55], s[94:95], v[12:13], v[18:19] op_sel_hi:[0,1,1]
    s_add_u32 s83, s82, 8
    s_min_u32 s83, s83, s73
    v_readlane_b32 s95, v24, s83
    v_readlane_b32 s94, v25, s83
    v_pk_add_f32 v[48:49], v[48:49], v[52:53]
    v_pk_add_f32 v[50:51], v[50:51], v[54:55]
    v_exp_f32 v52, v48
    v_exp_f32 v53, v49
    v_exp_f32 v54, v50
    v_exp_f32 v55, v51
    buffer_load_dwordx2 v[42:43], v2, s[28:31], s95 offen
    v_pk_add_f32 v[52:53], v[52:53], v[56:57]
    v_pk_add_f32 v[54:55], v[54:55], v[56:57]
    v_rcp_f32 v52, v52
    v_rcp_f32 v53, v53
    v_rcp_f32 v54, v54
    v_rcp_f32 v55, v55
    s_add_u32 s82, s82, 1
    v_pk_fma_f32 v[20:21], v[48:49], v[52:53], v[20:21]
    v_pk_fma_f32 v[22:23], v[50:51], v[54:55], v[22:23]
    s_cmp_ge_u32 s82, s69
    s_cbranch_scc1 Lm_ret
    s_waitcnt vmcnt(7)
    v_lshlrev_b32 v48, 16, v44
    v_and_b32 v49, 0xffff0000, v44
    v_lshlrev_b32 v50, 16, v45
    v_and_b32 v51, 0xffff0000, v45
    v_pk_fma_f32 v[52:53], s[96:97], v[10:11], v[16:17] op_sel_hi:[0,1,1]
    v_pk_fma_f32 v[54:55], s[96:97], v[12:13], v[18:19] op_sel_hi:[0,1,1]
    s_add_u32 s83, s82, 8
    s_min_u32 s83, s83, s73
    v_readlane_b32 s97, v24, s83
    v_readlane_b32 s96, v25, s83
    v_pk_add_f32 v[48:49], v[48:49], v[52:53]
    v_pk_add_f32 v[50:51], v[50:51], v[54:55]
    v_exp_f32 v52, v48
    v_exp_f32 v53, v49
    v_exp_f32 v54, v50
    v_exp_f32 v55, v51
    buffer_load_dwordx2 v[44:45], v2, s[28:31], s97 offen
    v_pk_add_f32 v[52:53], v[52:53], v[56:57]
    v_pk_add_f32 v[54:55], v[54:55], v[56:57]
    v_rcp_f32 v52, v52
    v_rcp_f32 v53, v53
    v_rcp_f32 v54, v54
    v_rcp_f32 v55, v55
    s_add_u32 s82, s82, 1
    v_pk_fma_f32 v[20:21], v[48:49], v[52:53], v[20:21]
    v_pk_fma_f32 v[22:23], v[50:51], v[54:55], v[22:23]
    s_cmp_ge_u32 s82, s69
    s_cbranch_scc1 Lm_ret
    s_waitcnt vmcnt(7)
    v_lshlrev_b32 v48, 16, v46
    v_and_b32 v49, 0xffff0000, v46
    v_lshlrev_b32 v50, 16, v47
    v_and_b32 v51, 0xffff0000, v47
    v_pk_fma_f32 v[52:53], s[98:99], v[10:11], v[16:17] op_sel_hi:[0,1,1]
    v_pk_fma_f32 v[54:55], s[98:99], v[12:13], v[18:19] op_sel_hi:[0,1,1]
    s_add_u32 s83, s82, 8
    s_min_u32 s83, s83, s73
    v_readlane_b32 s99, v24, s83
    v_readlane_b32 s98, v25, s83
    v_pk_add_f32 v[48:49], v[48:49], v[52:53]
    v_pk_add_f32 v[50:51], v[50:51], v[54:55]
    v_exp_f32 v52, v48
    v_exp_f32 v53, v49
    v_exp_f32 v54, v50
    v_exp_f32 v55, v51
    buffer_load_dwordx2 v[46:47], v2, s[28:31], s99 offen
    v_pk_add_f32 v[52:53], v[52:53], v[56:57]
    v_pk_add_f32 v[54:55], v[54:55], v[56:57]
    v_rcp_f32 v52, v52
    v_rcp_f32 v53, v53
    v_rcp_f32 v54, v54
    v_rcp_f32 v55, v55
    s_add_u32 s82, s82, 1
    v_pk_fma_f32 v[20:21], v[48:49], v[52:53], v[20:21]
    v_pk_fma_f32 v[22:23], v[50:51], v[54:55], v[22:23]
    s_cmp_ge_u32 s82, s69
    s_cbranch_scc1 Lm_ret
    s_branch Lm_loop
Lm_ret:
    s_setpc_b64 s[80:81]
Lm_done:
    s_waitcnt lgkmcnt(0)
    s_barrier
    v_lshrrev_b32 v5, 6, v0
    s_nop 1
    v_readfirstlane_b32 s66, v5
    v_and_b32 v6, 15, v1
    v_lshrrev_b32 v7, 4, v1
Lm_tile:
    s_cmp_ge_u32 s66, 24
    s_cbranch_scc1 Lm_end
    s_lshr_b32 s67, s66, 3
    s_and_b32 s68, s66, 7
    s_lshl_b32 s69, s68, 4
    v_add_u32 v8, s69, v6
    v_lshlrev_b32 v9, 9, v8
    v_lshl_add_u32 v9, v7, 4, v9
    buffer_load_dwordx4 v[32:35], v9, s[44:47], 0 offen offset:0
    buffer_load_dwordx4 v[36:39], v9, s[44:47], 0 offen offset:64
    buffer_load_dwordx4 v[40:43], v9, s[44:47], 0 offen offset:128
    buffer_load_dwordx4 v[44:47], v9, s[44:47], 0 offen offset:192
    buffer_load_dwordx4 v[48:51], v9, s[44:47], 0 offen offset:256
    buffer_load_dwordx4 v[52:55], v9, s[44:47], 0 offen offset:320
    buffer_load_dwordx4 v[56:59], v9, s[44:47], 0 offen offset:384
    buffer_load_dwordx4 v[60:63], v9, s[44:47], 0 offen offset:448
    v_lshlrev_b32 v10, 1, v8
    buffer_load_ushort v11, v10, s[56:59], 0 offen
    s_lshl_b32 s69, s67, 4
    v_add_u32 v12, s69, v6
    v_mul_u32_u24 v12, 528, v12
    v_lshl_add_u32 v12, v7, 4, v12
    ds_read_b128 v[64:67], v12 offset:0
    ds_read_b128 v[68:71], v12 offset:64
    ds_read_b128 v[72:75], v12 offset:128
    ds_read_b128 v[76:79], v12 offset:192
    ds_read_b128 v[80:83], v12 offset:256
    ds_read_b128 v[84:87], v12 offset:320
    ds_read_b128 v[88:91], v12 offset:384
    ds_read_b128 v[92:95], v12 offset:448
    v_lshl_add_u32 v13, v7, 2, s69
    v_lshlrev_b32 v14, 2, v13
    ds_read_b128 v[24:27], v14 offset:25344
    v_mov_b32 v20, 0
    v_mov_b32 v21, 0
    v_mov_b32 v22, 0
    v_mov_b32 v23, 0
    s_waitcnt vmcnt(0) lgkmcnt(0)
    v_mfma_f32_16x16x32_bf16 v[20:23], v[64:67], v[32:35], v[20:23]
    v_mfma_f32_16x16x32_bf16 v[20:23], v[68:71], v[36:39], v[20:23]
    v_mfma_f32_16x16x32_bf16 v[20:23], v[72:75], v[40:43], v[20:23]
    v_mfma_f32_16x16x32_bf16 v[20:23], v[76:79], v[44:47], v[20:23]
    v_mfma_f32_16x16x32_bf16 v[20:23], v[80:83], v[48:51], v[20:23]
    v_mfma_f32_16x16x32_bf16 v[20:23], v[84:87], v[52:55], v[20:23]
    v_mfma_f32_16x16x32_bf16 v[20:23], v[88:91], v[56:59], v[20:23]
    v_mfma_f32_16x16x32_bf16 v[20:23], v[92:95], v[60:63], v[20:23]
    v_lshlrev_b32 v11, 16, v11
    s_nop 6
    v_cvt_f32_u32 v24, v24
    v_fma_f32 v20, v24, v11, v20
    v_cvt_pk_bf16_f32 v20, v20, v20
    v_cvt_f32_u32 v25, v25
    v_fma_f32 v21, v25, v11, v21
    v_cvt_pk_bf16_f32 v21, v21, v21
    v_cvt_f32_u32 v26, v26
    v_fma_f32 v22, v26, v11, v22
    v_cvt_pk_bf16_f32 v22, v22, v22
    v_cvt_f32_u32 v27, v27
    v_fma_f32 v23, v27, v11, v23
    v_cvt_pk_bf16_f32 v23, v23, v23
    v_add_u32 v15, s60, v13
    v_lshlrev_b32 v15, 8, v15
    v_add_u32 v15, v15, v10
    v_mov_b32 v18, 0x7fff0000
    v_add_u32 v16, 0, v13
    v_cmp_gt_u32 vcc, s61, v16
    s_nop 1
    v_cndmask_b32 v17, v18, v15, vcc
    buffer_store_short v20, v17, s[48:51], 0 offen offset:0
    v_add_u32 v16, 1, v13
    v_cmp_gt_u32 vcc, s61, v16
    s_nop 1
    v_cndmask_b32 v17, v18, v15, vcc
    buffer_store_short v21, v17, s[48:51], 0 offen offset:256
    v_add_u32 v16, 2, v13
    v_cmp_gt_u32 vcc, s61, v16
    s_nop 1
    v_cndmask_b32 v17, v18, v15, vcc
    buffer_store_short v22, v17, s[48:51], 0 offen offset:512
    v_add_u32 v16, 3, v13
    v_cmp_gt_u32 vcc, s61, v16
    s_nop 1
    v_cndmask_b32 v17, v18, v15, vcc
    buffer_store_short v23, v17, s[48:51], 0 offen offset:768
    s_add_u32 s66, s66, 16
    s_branch Lm_tile
Lm_end:
    s_endpgm
.section .rodata,"a"
.p2align 6
.amdhsa_kernel prep_kernel
  .amdhsa_next_free_vgpr 128
  .amdhsa_next_free_sgpr 102
  .amdhsa_accum_offset 128
  .amdhsa_group_segment_fixed_size 0
  .amdhsa_kernarg_size 88
  .amdhsa_user_sgpr_count 2
  .amdhsa_user_sgpr_kernarg_segment_ptr 1
  .amdhsa_system_sgpr_workgroup_id_x 1
.end_amdhsa_kernel
.p2align 6
.amdhsa_kernel main_kernel
  .amdhsa_next_free_vgpr 128
  .amdhsa_next_free_sgpr 102
  .amdhsa_accum_offset 128
  .amdhsa_group_segment_fixed_size 0
  .amdhsa_kernarg_size 88
  .amdhsa_user_sgpr_count 2
  .amdhsa_user_sgpr_kernarg_segment_ptr 1
  .amdhsa_system_sgpr_workgroup_id_x 1
.end_amdhsa_kernel
```
